```python
import torch

def _softmax(x, axis=-1):
    return torch.softmax(x, dim=axis)
def _gelu(x):
    return torch.nn.functional.gelu(x, approximate="tanh")
def _silu(x):
    return torch.nn.functional.silu(x)
def _sigmoid(x):
    return torch.sigmoid(x)
def _layernorm(x, axis=-1, eps=1e-5):
    m = x.mean(dim=axis, keepdim=True)
    v = x.var(dim=axis, keepdim=True, unbiased=False)
    return (x - m) / torch.sqrt(v + eps)
def _scatter_add(tgt, idx, src, axis=0):
    return tgt.clone().index_add_(axis, idx, src)
def _segment_sum(src, seg, n):
    out = torch.zeros((n,) + src.shape[1:], dtype=src.dtype)
    return out.index_add_(0, seg, src)
def _pad(x, pw):
    flat = tuple(v for pair in reversed(pw) for v in pair)
    return torch.nn.functional.pad(x, flat)

kernel_name = 'parallel_sum__sliding_block_cached__dense_activation_silu__decode'

def setup_inputs():

    _w = (lambda a: (lambda t: t.to(torch.bfloat16) if t.is_floating_point() else t)(torch.as_tensor(a)))
    def _A_setup():
        B, Sq, D = 8, 1, 512
        Hq, Hkv, Sk, Dh = 32, 8, 4096, 128
        assert Hq % Hkv == 0, (Hq, Hkv)
        return {
            "x": _w((lambda *s: torch.randn(*s, dtype=torch.bfloat16) * 0.05)(B, Sq, D)),
            "k_cache": _w((lambda *s: torch.randn(*s, dtype=torch.bfloat16) * 3.2)(B, Hkv, Sk, Dh)),
            "v_cache": _w((lambda *s: torch.randn(*s, dtype=torch.bfloat16) * 0.8)(B, Hkv, Sk, Dh)),
            "wq": _w((lambda *s: torch.randn(*s, dtype=torch.bfloat16) * 3.2)(D, Hq * Dh) * (D ** -0.5)),
            "wo": _w((lambda *s: torch.randn(*s, dtype=torch.bfloat16) * 0.8)(Hq * Dh, D) * ((Hq * Dh) ** -0.5)),
        }
    _A_in = _A_setup()

    def _B_setup():
        B, S, D, F = 8, 1, 512, 1792
        return {
            "x": _w((lambda *s: torch.randn(*s, dtype=torch.bfloat16) * 0.05)(B, S, D)),
            "w1": _w((lambda *s: torch.randn(*s, dtype=torch.bfloat16) * 3.2)(D, F) * (D ** -0.5)),
            "w2": _w((lambda *s: torch.randn(*s, dtype=torch.bfloat16) * 0.4)(F, D) * (F ** -0.5)),
        }
    _B_in = _B_setup()

    return {
        "A_x": _A_in["x"],
        "A_k_cache": _A_in["k_cache"],
        "A_v_cache": _A_in["v_cache"],
        "A_wq": _A_in["wq"],
        "A_wo": _A_in["wo"],
        "B_x": _B_in["x"],
        "B_w1": _B_in["w1"],
        "B_w2": _B_in["w2"],
    }

def reference(A_x, A_k_cache, A_v_cache, A_wq, A_wo, B_x, B_w1, B_w2):
    def _A_ref(x, k_cache, v_cache, wq, wo):
        B, Sq, D = x.shape
        Hq, Dh = 32, 128
        Hkv, Sk = k_cache.shape[1], k_cache.shape[2]
        W = min(4096, max(256, Sk // 4))
        rep = Hq // Hkv
        q = (lambda x, *d: x.permute(*d))((x @ wq).reshape(B, Sq, Hq, Dh), 0, 2, 1, 3)
        k = (lambda x, n, axis: torch.repeat_interleave(x, n, dim=axis))(k_cache[:, :, Sk - W:, :], rep, axis=1)
        v = (lambda x, n, axis: torch.repeat_interleave(x, n, dim=axis))(v_cache[:, :, Sk - W:, :], rep, axis=1)
        scores = torch.einsum("bhqd,bhkd->bhqk", q, k) * (Dh ** -0.5)
        p = _softmax(scores, axis=-1)
        o = torch.einsum("bhqk,bhkd->bhqd", p, v)
        return (lambda x, *d: x.permute(*d))(o, 0, 2, 1, 3).reshape(B, Sq, Hq * Dh) @ wo

    def _B_ref(x, w1, w2):
        h = torch.einsum("bsd,df->bsf", x, w1)
        h = _silu(h)
        out = torch.einsum("bsf,fd->bsd", h, w2)
        return out

    x = A_x
    xn = _layernorm(x, axis=-1)
    return x + _A_ref(xn, A_k_cache, A_v_cache, A_wq, A_wo) + _B_ref(xn, B_w1, B_w2)
```

```asm
; @launch grid=(256,1,1) block=(576,1,1) lds=163840
.amdgcn_target "amdgcn-amd-amdhsa--gfx950"
.text
.p2align 12
.fill 832, 4, 0xbf810000
.globl parallel_sum__sliding_block_cached__dense_activation_silu__decode_kernel
.p2align 8
.type parallel_sum__sliding_block_cached__dense_activation_silu__decode_kernel,@function
parallel_sum__sliding_block_cached__dense_activation_silu__decode_kernel:
    s_cmp_ge_u32 s2, 256
    s_cbranch_scc1 L_end
    s_load_dwordx16 s[4:19], s[0:1], 0
    s_load_dwordx4 s[20:23], s[0:1], 64
    s_load_dwordx2 s[24:25], s[0:1], 80
    s_getpc_b64 s[38:39]
    v_lshrrev_b32 v1, 6, v0
    v_and_b32 v0, 63, v0
    s_and_b32 s26, s2, 7
    v_readfirstlane_b32 s30, v1
    s_lshr_b32 s27, s2, 3
    s_lshr_b32 s28, s2, 5
    s_mov_b32 s3, s28
    s_xor_b32 s64, s3, 3
    s_and_b32 s29, s27, 3
    s_lshl_b32 s33, s26, 2
    s_add_u32 s33, s33, s29
    s_sub_u32 s34, s33, 4
    s_and_b32 s34, s34, 31
    s_min_u32 s34, s34, 27
    v_lshrrev_b32 v3, 4, v0
    v_mov_b32 v8, 160384
    v_mov_b32 v9, 1
    s_sub_u32 s30, s30, 1
    s_cbranch_scc0 L_ce
    s_setprio 3
    v_lshrrev_b32 v4, 3, v0
    v_and_b32 v5, 7, v0
    v_and_b32 v1, 2, v4
    v_xor_b32 v5, v5, v1
    v_lshlrev_b32 v5, 4, v5
    s_lshl_b32 s35, s29, 20
    s_lshl_b32 s42, s26, 10
    s_add_u32 s35, s35, s42
    s_lshl_b32 s44, s3, 7
    s_add_u32 s35, s35, s44
    v_lshl_add_u32 v10, v4, 13, v5
    v_add_u32 v10, s35, v10
    v_add_u32 v11, 64512, v10
    v_add_u32 v12, 129024, v10
    v_xor_b32 v11, 64, v11
    v_add_u32 v13, 129024, v11
    s_mov_b32 m0, 131072
    s_waitcnt lgkmcnt(0)
    global_load_lds_dwordx4 v10, s[10:11] offset:0 nt
    global_load_lds_dwordx4 v11, s[10:11] offset:1024 nt
    global_load_lds_dwordx4 v12, s[10:11] offset:2048 nt
    global_load_lds_dwordx4 v13, s[10:11] offset:3072 nt
    s_addk_i32 m0, 4096
    s_add_u32 s10, s10, 262144
    s_addc_u32 s11, s11, 0
    global_load_lds_dwordx4 v10, s[10:11] offset:0 nt
    global_load_lds_dwordx4 v11, s[10:11] offset:1024 nt
    global_load_lds_dwordx4 v12, s[10:11] offset:2048 nt
    global_load_lds_dwordx4 v13, s[10:11] offset:3072 nt
    s_addk_i32 m0, 4096
    s_add_u32 s10, s10, 262144
    s_addc_u32 s11, s11, 0
    global_load_lds_dwordx4 v10, s[10:11] offset:0 nt
    global_load_lds_dwordx4 v11, s[10:11] offset:1024 nt
    global_load_lds_dwordx4 v12, s[10:11] offset:2048 nt
    global_load_lds_dwordx4 v13, s[10:11] offset:3072 nt
    s_addk_i32 m0, 4096
    s_add_u32 s10, s10, 262144
    s_addc_u32 s11, s11, 0
    global_load_lds_dwordx4 v10, s[10:11] offset:0 nt
    global_load_lds_dwordx4 v11, s[10:11] offset:1024 nt
    global_load_lds_dwordx4 v12, s[10:11] offset:2048 nt
    global_load_lds_dwordx4 v13, s[10:11] offset:3072 nt
    s_addk_i32 m0, 4096
    s_nop 0
    s_branch L_ld2
L_ce:
    s_lshl_b32 s35, s30, 5
    s_add_u32 s35, s35, s27
    s_lshl_b32 s35, s35, 7
    v_mov_b32 v1, s35
    v_lshl_add_u32 v2, v0, 2, v8
    v_mov_b32 v4, 0
    s_mov_b64 exec, 0xffff
    ds_write_b32 v2, v4
    s_cmp_ge_u32 s35, L_end-parallel_sum__sliding_block_cached__dense_activation_silu__decode_kernel
    s_cbranch_scc1 L_nocode
    s_mov_b64 exec, 1
    global_load_dword v5, v1, s[38:39]
L_nocode:
    s_mov_b64 exec, -1
    s_lshl_b32 s35, s30, 10
    v_lshl_add_u32 v10, v0, 4, s35
    s_waitcnt lgkmcnt(0)
    global_load_dwordx4 v[16:19], v10, s[4:5]
    s_mov_b32 s42, 2064384
    s_load_dword s31, s[24:25], s42
    s_barrier
    s_branch L_c
L_ld2:
    s_barrier
    s_mul_i32 s35, s3, 229376
    s_lshl_b32 s42, s34, 7
    s_add_u32 s35, s35, s42
    v_mul_u32_u24 v24, 3584, v4
    v_add3_u32 v24, v24, v5, s35
    v_add_u32 v25, 27648, v24
    v_add_u32 v26, 55296, v24
    v_xor_b32 v25, 64, v25
    v_add_u32 v27, 55296, v25
    s_lshl_b32 s42, s28, 3
    s_add_u32 s42, s42, s26
    s_lshl_b32 s42, s42, 20
    s_lshl_b32 s43, s29, 16
    s_add_u32 s42, s42, s43
    s_add_u32 s42, s42, 786432
    v_and_b32 v1, 15, v0
    v_lshl_add_u32 v2, v3, 8, s42
    v_xor_b32 v20, v1, v3
    v_lshl_add_u32 v20, v20, 4, v2
    v_lshlrev_b32 v14, 1, v3
    v_xor_b32 v14, v1, v14
    v_lshl_add_u32 v14, v14, 4, v2
    v_xor_b32 v21, 64, v20
    v_xor_b32 v22, 128, v20
    v_xor_b32 v23, 192, v20
    v_xor_b32 v15, 128, v14
    s_mov_b32 s30, 8
    s_lshl_b32 s52, s29, 1
    s_add_u32 s52, s52, s28
    s_and_b32 s52, s52, 15
    s_lshl_b32 s52, s52, 12
    s_cmp_eq_u32 s26, 0
    s_cbranch_scc1 L_only1
    s_mov_b32 m0, 147456
    s_mov_b32 s35, 2
L_g0:
    global_load_lds_dwordx4 v24, s[16:17] offset:0 nt
    global_load_lds_dwordx4 v25, s[16:17] offset:1024 nt
    global_load_lds_dwordx4 v26, s[16:17] offset:2048 nt
    global_load_lds_dwordx4 v27, s[16:17] offset:3072 nt
    s_addk_i32 m0, 4096
    s_add_u32 s16, s16, 114688
    s_addc_u32 s17, s17, 0
    s_sub_u32 s35, s35, 1
    s_cmp_lg_u32 s35, 0
    s_cbranch_scc1 L_g0
L_only1:
    v_lshl_add_u32 v1, v4, 10, v5
    s_lshl_b32 s44, s64, 7
    s_lshl_b32 s42, s33, 17
    s_add_u32 s42, s42, s44
    v_add_u32 v32, s42, v1
    v_add_u32 v33, 7168, v32
    v_add_u32 v34, 14336, v32
    v_xor_b32 v33, 64, v33
    v_add_u32 v35, 14336, v33
    s_lshl_b32 s42, s34, 16
    s_add_u32 s42, s42, s44
    v_add_u32 v28, s42, v1
    v_add_u32 v29, 7168, v28
    v_add_u32 v30, 14336, v28
    v_xor_b32 v29, 64, v29
    v_add_u32 v31, 14336, v29
    s_mov_b32 m0, 0
    s_mov_b32 s35, 6
L_g2:
    s_add_u32 s50, s6, s52
    s_addc_u32 s51, s7, 0
    s_waitcnt vmcnt(23)
    global_load_lds_dwordx4 v20, s[50:51] offset:0 nt
    s_waitcnt vmcnt(23)
    global_load_lds_dwordx4 v21, s[50:51] offset:1024 nt
    s_waitcnt vmcnt(23)
    global_load_lds_dwordx4 v22, s[50:51] offset:2048 nt
    s_waitcnt vmcnt(23)
    global_load_lds_dwordx4 v23, s[50:51] offset:3072 nt
    s_addk_i32 s52, 4096
    s_and_b32 s52, s52, 0xffff
    s_addk_i32 m0, 4096
    s_sub_u32 s35, s35, 1
    s_cmp_lg_u32 s35, 0
    s_cbranch_scc1 L_g2
    s_mov_b64 exec, 1
    ds_add_u32 v8, v9 offset:4
    s_mov_b64 exec, -1
    s_mov_b32 m0, 24576
    s_mov_b32 s35, 5
L_g8:
    s_add_u32 s50, s6, s52
    s_addc_u32 s51, s7, 0
    s_waitcnt vmcnt(23)
    global_load_lds_dwordx4 v20, s[50:51] offset:0 nt
    s_waitcnt vmcnt(23)
    global_load_lds_dwordx4 v21, s[50:51] offset:1024 nt
    s_waitcnt vmcnt(23)
    global_load_lds_dwordx4 v22, s[50:51] offset:2048 nt
    s_waitcnt vmcnt(23)
    global_load_lds_dwordx4 v23, s[50:51] offset:3072 nt
    s_addk_i32 s52, 4096
    s_and_b32 s52, s52, 0xffff
    s_addk_i32 m0, 4096
    s_sub_u32 s35, s35, 1
    s_cmp_lg_u32 s35, 0
    s_cbranch_scc1 L_g8
    ds_write_b32 v8, v9 offset:0
    s_mov_b32 m0, 45056
    s_mov_b32 s35, 5
L_g13:
    s_add_u32 s50, s6, s52
    s_addc_u32 s51, s7, 0
    s_waitcnt vmcnt(23)
    global_load_lds_dwordx4 v20, s[50:51] offset:0 nt
    s_waitcnt vmcnt(23)
    global_load_lds_dwordx4 v21, s[50:51] offset:1024 nt
    s_waitcnt vmcnt(23)
    global_load_lds_dwordx4 v22, s[50:51] offset:2048 nt
    s_waitcnt vmcnt(23)
    global_load_lds_dwordx4 v23, s[50:51] offset:3072 nt
    s_addk_i32 s52, 4096
    s_and_b32 s52, s52, 0xffff
    s_addk_i32 m0, 4096
    s_sub_u32 s35, s35, 1
    s_cmp_lg_u32 s35, 0
    s_cbranch_scc1 L_g13
    s_mov_b32 m0, 65536
    s_mov_b32 s35, 6
L_g18:
    s_add_u32 s50, s8, s52
    s_addc_u32 s51, s9, 0
    s_waitcnt vmcnt(23)
    global_load_lds_dwordx4 v14, s[50:51] offset:0 nt
    s_waitcnt vmcnt(23)
    global_load_lds_dwordx4 v14, s[50:51] offset:1024 nt
    s_waitcnt vmcnt(23)
    global_load_lds_dwordx4 v15, s[50:51] offset:2048 nt
    s_waitcnt vmcnt(23)
    global_load_lds_dwordx4 v15, s[50:51] offset:3072 nt
    s_addk_i32 s52, 4096
    s_and_b32 s52, s52, 0xffff
    s_addk_i32 m0, 4096
    s_sub_u32 s35, s35, 1
    s_cmp_lg_u32 s35, 0
    s_cbranch_scc1 L_g18
    ds_write_b32 v8, v9 offset:24
L_wfree:
    ds_read_b32 v1, v8 offset:8
    s_waitcnt lgkmcnt(0)
    v_readfirstlane_b32 s35, v1
    s_cmp_lt_u32 s35, 8
    s_cbranch_scc1 L_wfree
    s_mov_b32 m0, 90112
    s_mov_b32 s35, 2
L_g24:
    s_add_u32 s50, s8, s52
    s_addc_u32 s51, s9, 0
    s_waitcnt vmcnt(23)
    global_load_lds_dwordx4 v14, s[50:51] offset:0 nt
    s_waitcnt vmcnt(23)
    global_load_lds_dwordx4 v14, s[50:51] offset:1024 nt
    s_waitcnt vmcnt(23)
    global_load_lds_dwordx4 v15, s[50:51] offset:2048 nt
    s_waitcnt vmcnt(23)
    global_load_lds_dwordx4 v15, s[50:51] offset:3072 nt
    s_addk_i32 s52, 4096
    s_and_b32 s52, s52, 0xffff
    s_addk_i32 m0, 4096
    s_sub_u32 s35, s35, 1
    s_cmp_lg_u32 s35, 0
    s_cbranch_scc1 L_g24
    s_mov_b32 m0, 98304
    s_mov_b32 s35, 8
L_g26:
    s_add_u32 s50, s8, s52
    s_addc_u32 s51, s9, 0
    s_waitcnt vmcnt(19)
    global_load_lds_dwordx4 v14, s[50:51] offset:0 nt
    s_waitcnt vmcnt(19)
    global_load_lds_dwordx4 v14, s[50:51] offset:1024 nt
    s_waitcnt vmcnt(19)
    global_load_lds_dwordx4 v15, s[50:51] offset:2048 nt
    s_waitcnt vmcnt(19)
    global_load_lds_dwordx4 v15, s[50:51] offset:3072 nt
    s_addk_i32 s52, 4096
    s_and_b32 s52, s52, 0xffff
    s_addk_i32 m0, 4096
    s_sub_u32 s35, s35, 1
    s_cmp_lg_u32 s35, 0
    s_cbranch_scc1 L_g26
    s_cmp_eq_u32 s26, 0
    s_cbranch_scc1 L_only2
    s_mov_b32 m0, 147456
    s_waitcnt vmcnt(19)
    global_load_lds_dwordx4 v28, s[18:19] offset:0 nt
    s_waitcnt vmcnt(19)
    global_load_lds_dwordx4 v29, s[18:19] offset:1024 nt
    s_waitcnt vmcnt(19)
    global_load_lds_dwordx4 v30, s[18:19] offset:2048 nt
    s_waitcnt vmcnt(19)
    global_load_lds_dwordx4 v31, s[18:19] offset:3072 nt
    s_addk_i32 m0, 4096
    s_add_u32 s18, s18, 32768
    s_addc_u32 s19, s19, 0
L_only2:
    s_cmp_eq_u32 s26, 0
    s_cbranch_scc1 L_only3
    ds_write_b32 v8, v9 offset:28
L_only3:
    s_cmp_eq_u32 s26, 0
    s_cbranch_scc1 L_only4
    s_mov_b32 m0, 151552
    s_waitcnt vmcnt(19)
    global_load_lds_dwordx4 v28, s[18:19] offset:0 nt
    s_waitcnt vmcnt(19)
    global_load_lds_dwordx4 v29, s[18:19] offset:1024 nt
    s_waitcnt vmcnt(19)
    global_load_lds_dwordx4 v30, s[18:19] offset:2048 nt
    s_waitcnt vmcnt(19)
    global_load_lds_dwordx4 v31, s[18:19] offset:3072 nt
    s_addk_i32 m0, 4096
    s_add_u32 s18, s18, 32768
    s_addc_u32 s19, s19, 0
L_only4:
    s_mov_b32 m0, 131072
    s_waitcnt vmcnt(19)
    global_load_lds_dwordx4 v32, s[12:13] offset:0 nt
    s_waitcnt vmcnt(19)
    global_load_lds_dwordx4 v33, s[12:13] offset:1024 nt
    s_waitcnt vmcnt(19)
    global_load_lds_dwordx4 v34, s[12:13] offset:2048 nt
    s_waitcnt vmcnt(19)
    global_load_lds_dwordx4 v35, s[12:13] offset:3072 nt
    s_addk_i32 m0, 4096
    s_add_u32 s12, s12, 32768
    s_addc_u32 s13, s13, 0
    s_cmp_eq_u32 s26, 0
    s_cbranch_scc0 L_only5
    ds_write_b32 v8, v9 offset:28
L_only5:
    s_cmp_eq_u32 s26, 0
    s_cbranch_scc1 L_only6
    ds_write_b32 v8, v9 offset:32
L_only6:
    s_mov_b32 m0, 135168
    s_mov_b32 s35, 2
L_g37:
    s_waitcnt vmcnt(19)
    global_load_lds_dwordx4 v32, s[12:13] offset:0 nt
    s_waitcnt vmcnt(19)
    global_load_lds_dwordx4 v33, s[12:13] offset:1024 nt
    s_waitcnt vmcnt(19)
    global_load_lds_dwordx4 v34, s[12:13] offset:2048 nt
    s_waitcnt vmcnt(19)
    global_load_lds_dwordx4 v35, s[12:13] offset:3072 nt
    s_addk_i32 m0, 4096
    s_add_u32 s12, s12, 32768
    s_addc_u32 s13, s13, 0
    s_sub_u32 s35, s35, 1
    s_cmp_lg_u32 s35, 0
    s_cbranch_scc1 L_g37
    s_cmp_eq_u32 s26, 0
    s_cbranch_scc0 L_only7
    ds_write_b32 v8, v9 offset:32
L_only7:
    s_cmp_eq_u32 s26, 0
    s_cbranch_scc1 L_only8
    s_barrier
L_only8:
    s_mov_b32 m0, 143360
    s_waitcnt vmcnt(19)
    global_load_lds_dwordx4 v32, s[12:13] offset:0 nt
    s_waitcnt vmcnt(19)
    global_load_lds_dwordx4 v33, s[12:13] offset:1024 nt
    s_waitcnt vmcnt(19)
    global_load_lds_dwordx4 v34, s[12:13] offset:2048 nt
    s_waitcnt vmcnt(19)
    global_load_lds_dwordx4 v35, s[12:13] offset:3072 nt
    s_addk_i32 m0, 4096
    s_add_u32 s12, s12, 32768
    s_addc_u32 s13, s13, 0
    s_cmp_eq_u32 s26, 0
    s_cbranch_scc0 L_only9
    s_waitcnt vmcnt(16)
    s_barrier
L_only9:
    s_waitcnt vmcnt(8)
    s_barrier
    s_waitcnt vmcnt(0)
    s_barrier
    s_branch L_fin
L_c:
    s_and_b32 s47, s30, 3
    v_and_b32 v1, 3, v0
    v_lshl_add_u32 v1, v1, 2, v3
    s_lshl_b32 s35, s28, 9
    s_lshl_b32 s42, s33, 4
    s_add_u32 s35, s35, s42
    v_add_lshl_u32 v117, v1, s35, 1
    v_bfe_u32 v2, v0, 2, 2
    v_lshl_add_u32 v1, v3, 3, v2
    v_bfe_u32 v2, v0, 3, 2
    v_xor_b32 v2, s47, v2
    v_lshlrev_b32 v2, 5, v2
    v_lshl_add_u32 v1, v1, 7, v2
    v_and_b32 v2, 3, v0
    v_lshl_add_u32 v1, v2, 3, v1
    v_add_u32 v7, 131072, v1
    s_mul_i32 s35, s30, 416
    s_add_u32 s35, s35, 160448
    v_and_b32 v2, 15, v0
    v_lshl_add_u32 v10, v2, 4, s35
    v_and_b32 v1, 7, v0
    v_lshl_add_u32 v11, v1, 4, s35
    s_lshl_b32 s35, s29, 4
    s_lshl_b64 s[50:51], 0xffff, s35
    s_lshl_b32 s35, s3, 3
    s_lshl_b64 s[52:53], 0xff, s35
    s_lshl_b32 s35, s33, 1
    s_lshl_b64 s[56:57], 3, s35
    v_mul_u32_u24 v12, 416, v1
    v_lshl_add_u32 v12, v3, 4, v12
    v_add_u32 v12, 160448, v12
    v_and_b32 v14, 1, v0
    v_lshlrev_b32 v14, 4, v14
    v_add_u32 v14, 163776, v14
    s_lshl_b32 s43, s47, 6
    v_lshl_add_u32 v1, v3, 4, s43
    s_lshl_b32 s35, s26, 16
    s_lshl_b32 s42, s29, 11
    s_add_u32 s35, s35, s42
    s_lshl_b32 s42, s3, 8
    s_add_u32 s35, s35, s42
    s_add_u32 s35, s35, 32768
    s_lshl_b32 s43, s34, 14
    s_lshl_b32 s42, s3, 11
    s_add_u32 s43, s43, s42
    s_add_u32 s43, s43, 557056
    s_cmp_lt_u32 s30, 4
    s_cselect_b32 s35, s35, s43
    s_cselect_b32 s42, 13, 8
    v_lshlrev_b32 v116, s42, v2
    v_add3_u32 v116, v116, v1, s35
    s_mov_b32 s55, 0
    s_waitcnt vmcnt(0)
L_xok:
    s_cmp_lg_u32 s30, s28
    s_cbranch_scc1 L_noxr
    s_mov_b64 exec, s[56:57]
    ds_write_b128 v14, v[16:19]
    s_mov_b64 exec, -1
L_noxr:
    v_lshlrev_b32 v20, 16, v16
    v_and_b32 v21, 0xffff0000, v16
    v_lshlrev_b32 v22, 16, v17
    v_and_b32 v23, 0xffff0000, v17
    v_lshlrev_b32 v24, 16, v18
    v_and_b32 v25, 0xffff0000, v18
    v_lshlrev_b32 v26, 16, v19
    v_and_b32 v27, 0xffff0000, v19
    v_add_f32 v28, v20, v21
    v_add_f32 v29, v22, v23
    v_add_f32 v30, v24, v25
    v_add_f32 v31, v26, v27
    v_add_f32 v28, v28, v29
    v_add_f32 v30, v30, v31
    v_add_f32 v28, v28, v30
    s_nop 1
    v_add_f32_dpp v28, v28, v28 quad_perm:[1,0,3,2] row_mask:0xf bank_mask:0xf
    s_nop 1
    v_add_f32_dpp v28, v28, v28 quad_perm:[2,3,0,1] row_mask:0xf bank_mask:0xf
    s_nop 1
    v_add_f32_dpp v28, v28, v28 row_half_mirror row_mask:0xf bank_mask:0xf
    s_nop 1
    v_add_f32_dpp v28, v28, v28 row_mirror row_mask:0xf bank_mask:0xf
    s_nop 1
    v_add_f32_dpp v28, v28, v28 row_bcast:15 row_mask:0xa bank_mask:0xf
    s_nop 1
    v_add_f32_dpp v28, v28, v28 row_bcast:31 row_mask:0xc bank_mask:0xf
    v_mul_f32 v28, 0x3b000000, v28
    v_cvt_pk_bf16_f32 v29, v28, v28
    v_readlane_b32 s35, v28, 63
    v_readlane_b32 s43, v29, 63
    s_nop 0
    v_subrev_f32 v32, s35, v20
    v_subrev_f32 v33, s35, v21
    v_subrev_f32 v34, s35, v22
    v_subrev_f32 v35, s35, v23
    v_subrev_f32 v36, s35, v24
    v_subrev_f32 v37, s35, v25
    v_subrev_f32 v38, s35, v26
    v_subrev_f32 v39, s35, v27
    s_lshl_b32 s43, s43, 16
    v_mul_f32 v28, v32, v32
    v_mul_f32 v29, v33, v33
    v_fmac_f32 v28, v34, v34
    v_fmac_f32 v29, v35, v35
    v_fmac_f32 v28, v36, v36
    v_fmac_f32 v29, v37, v37
    v_fmac_f32 v28, v38, v38
    v_fmac_f32 v29, v39, v39
    v_add_f32 v28, v28, v29
    s_nop 1
    v_add_f32_dpp v28, v28, v28 quad_perm:[1,0,3,2] row_mask:0xf bank_mask:0xf
    s_nop 1
    v_add_f32_dpp v28, v28, v28 quad_perm:[2,3,0,1] row_mask:0xf bank_mask:0xf
    s_nop 1
    v_add_f32_dpp v28, v28, v28 row_half_mirror row_mask:0xf bank_mask:0xf
    s_nop 1
    v_add_f32_dpp v28, v28, v28 row_mirror row_mask:0xf bank_mask:0xf
    s_nop 1
    v_add_f32_dpp v28, v28, v28 row_bcast:15 row_mask:0xa bank_mask:0xf
    s_nop 1
    v_add_f32_dpp v28, v28, v28 row_bcast:31 row_mask:0xc bank_mask:0xf
    v_mul_f32 v28, 0x3b000000, v28
    v_cvt_pk_bf16_f32 v28, v28, v28
    v_lshlrev_b32 v28, 16, v28
    v_add_f32 v28, 0x3727c5ac, v28
    v_cvt_pk_bf16_f32 v28, v28, v28
    v_lshlrev_b32 v28, 16, v28
    v_sqrt_f32 v28, v28
    v_subrev_f32 v20, s43, v20
    v_subrev_f32 v21, s43, v21
    v_subrev_f32 v22, s43, v22
    v_subrev_f32 v23, s43, v23
    v_subrev_f32 v24, s43, v24
    v_subrev_f32 v25, s43, v25
    v_subrev_f32 v26, s43, v26
    v_subrev_f32 v27, s43, v27
    v_cvt_pk_bf16_f32 v28, v28, v28
    v_lshlrev_b32 v28, 16, v28
    v_rcp_f32 v29, v28
    v_cvt_pk_bf16_f32 v30, v20, v21
    v_lshlrev_b32 v20, 16, v30
    v_and_b32 v21, 0xffff0000, v30
    v_cvt_pk_bf16_f32 v31, v22, v23
    v_lshlrev_b32 v22, 16, v31
    v_and_b32 v23, 0xffff0000, v31
    v_cvt_pk_bf16_f32 v30, v24, v25
    v_lshlrev_b32 v24, 16, v30
    v_and_b32 v25, 0xffff0000, v30
    v_cvt_pk_bf16_f32 v31, v26, v27
    v_lshlrev_b32 v26, 16, v31
    v_and_b32 v27, 0xffff0000, v31
    v_readlane_b32 s35, v28, 63
    v_readlane_b32 s45, v29, 63
    s_nop 1
    v_mul_f32 v32, s45, v20
    v_mul_f32 v33, s45, v21
    v_mul_f32 v34, s45, v22
    v_mul_f32 v35, s45, v23
    v_mul_f32 v36, s45, v24
    v_mul_f32 v37, s45, v25
    v_mul_f32 v38, s45, v26
    v_mul_f32 v39, s45, v27
    v_fma_f32 v20, -v32, s35, v20
    v_fma_f32 v21, -v33, s35, v21
    v_fma_f32 v22, -v34, s35, v22
    v_fma_f32 v23, -v35, s35, v23
    v_fma_f32 v24, -v36, s35, v24
    v_fma_f32 v25, -v37, s35, v25
    v_fma_f32 v26, -v38, s35, v26
    v_fma_f32 v27, -v39, s35, v27
    v_fma_f32 v32, v20, s45, v32
    v_fma_f32 v33, v21, s45, v33
    v_fma_f32 v34, v22, s45, v34
    v_fma_f32 v35, v23, s45, v35
    v_fma_f32 v36, v24, s45, v36
    v_fma_f32 v37, v25, s45, v37
    v_fma_f32 v38, v26, s45, v38
    v_fma_f32 v39, v27, s45, v39
    v_cvt_pk_bf16_f32 v16, v32, v33
    v_cvt_pk_bf16_f32 v17, v34, v35
    v_cvt_pk_bf16_f32 v18, v36, v37
    v_cvt_pk_bf16_f32 v19, v38, v39
    s_mov_b64 exec, s[50:51]
    ds_write_b128 v10, v[16:19]
    s_mov_b64 exec, s[52:53]
    ds_write_b128 v11, v[16:19] offset:256
    s_mov_b64 exec, 1
    ds_add_u32 v8, v9 offset:4
    s_mov_b64 exec, -1
    s_waitcnt lgkmcnt(0)
    s_add_u32 s31, s31, 1
    s_and_b32 s68, s31, 0xff
    s_lshr_b32 s69, s31, 8
    s_add_u32 s69, s69, s31
    s_and_b32 s69, s69, 0xff
    s_lshr_b32 s70, s31, 16
    s_add_u32 s70, s70, s31
    s_and_b32 s70, s70, 0xff
    s_lshr_b32 s71, s31, 24
    s_add_u32 s71, s71, s31
    s_and_b32 s71, s71, 0xff
    s_mov_b32 s36, 0xffffff00
    v_mov_b32 v6, s36
    s_getreg_b32 s42, hwreg(HW_REG_XCC_ID, 0, 4)
    s_lshl_b32 s60, s42, 8
    s_and_b32 s60, s60, 0x100
    s_or_b32 s60, s60, s68
    s_lshl_b32 s61, s42, 7
    s_and_b32 s61, s61, 0x100
    s_or_b32 s61, s61, s69
    s_lshl_b32 s62, s42, 6
    s_and_b32 s62, s62, 0x100
    s_or_b32 s62, s62, s70
    s_lshl_b32 s63, s42, 5
    s_and_b32 s63, s63, 0x100
    s_or_b32 s63, s63, s71
    v_mov_b32 v60, 0xfffffe00
    s_branch L_s0
L_s0_z:
    s_sleep 1
L_s0:
    ds_read_b32 v1, v8 offset:4
    s_waitcnt lgkmcnt(0)
    v_readfirstlane_b32 s35, v1
    s_cmp_lt_u32 s35, 9
    s_cbranch_scc1 L_s0_z
    s_cmp_ge_u32 s30, 4
    s_cbranch_scc1 L_hproj
    ds_read_b64_tr_b16 v[24:25], v7 offset:0
    ds_read_b64_tr_b16 v[26:27], v7 offset:512
    ds_read_b128 v[40:43], v12 offset:0
    ds_read_b64_tr_b16 v[28:29], v7 offset:4096
    ds_read_b64_tr_b16 v[30:31], v7 offset:4608
    ds_read_b128 v[44:47], v12 offset:64
    ds_read_b64_tr_b16 v[32:33], v7 offset:8192
    ds_read_b64_tr_b16 v[34:35], v7 offset:8704
    ds_read_b128 v[48:51], v12 offset:128
    ds_read_b64_tr_b16 v[36:37], v7 offset:12288
    ds_read_b64_tr_b16 v[38:39], v7 offset:12800
    ds_read_b128 v[52:55], v12 offset:192
    s_waitcnt lgkmcnt(9)
    v_mfma_f32_16x16x32_bf16 v[112:115], v[24:27], v[40:43], 0
    s_waitcnt lgkmcnt(6)
    v_mfma_f32_16x16x32_bf16 v[112:115], v[28:31], v[44:47], v[112:115]
    s_waitcnt lgkmcnt(3)
    v_mfma_f32_16x16x32_bf16 v[112:115], v[32:35], v[48:51], v[112:115]
    s_waitcnt lgkmcnt(0)
    v_mfma_f32_16x16x32_bf16 v[112:115], v[36:39], v[52:55], v[112:115]
    s_mov_b32 exec_lo, 0x00ff00ff
    s_mov_b32 exec_hi, 0x00ff00ff
    s_nop 5
    v_and_or_b32 v112, v112, v60, s60
    v_and_or_b32 v113, v113, v60, s61
    v_and_or_b32 v114, v114, v60, s62
    v_and_or_b32 v115, v115, v60, s63
    s_branch L_pub
L_hproj:
    s_cmp_eq_u32 s26, 0
    s_cselect_b32 s55, 1, 0
    s_cbranch_scc1 L_pq_ok
    ds_read_b64_tr_b16 v[24:25], v7 offset:16384
    ds_read_b64_tr_b16 v[26:27], v7 offset:16896
    ds_read_b128 v[40:43], v12 offset:256
    ds_read_b64_tr_b16 v[28:29], v7 offset:20480
    ds_read_b64_tr_b16 v[30:31], v7 offset:20992
    ds_read_b128 v[44:47], v12 offset:320
    s_waitcnt lgkmcnt(3)
    v_mfma_f32_16x16x32_bf16 v[112:115], v[24:27], v[40:43], 0
    s_waitcnt lgkmcnt(0)
    v_mfma_f32_16x16x32_bf16 v[112:115], v[28:31], v[44:47], v[112:115]
    s_mov_b32 exec_lo, 0x00ff00ff
    s_mov_b32 exec_hi, 0x00ff00ff
    s_nop 5
    v_and_or_b32 v112, v112, v6, s68
    v_and_or_b32 v113, v113, v6, s69
    v_and_or_b32 v114, v114, v6, s70
    v_and_or_b32 v115, v115, v6, s71
L_pub:
    global_store_dwordx4 v116, v[112:115], s[24:25]
L_pq_ok:
    s_mov_b64 exec, 1
    ds_add_u32 v8, v9 offset:8
    s_mov_b64 exec, -1
    v_and_b32 v2, 15, v0
    v_lshlrev_b32 v1, 11, v3
    v_lshl_add_u32 v1, v2, 4, v1
    s_lshl_b32 s35, s26, 16
    s_lshl_b32 s42, s28, 13
    s_add_u32 s35, s35, s42
    s_lshl_b32 s42, s30, 8
    s_add_u32 s35, s35, s42
    s_add_u32 s35, s35, 32768
    v_add_u32 v10, s35, v1
    s_lshl_b32 s35, s34, 14
    s_add_u32 s35, s35, s42
    s_add_u32 s35, s35, 557056
    v_add_u32 v11, s35, v1
    v_add_u32 v12, 0x2000, v11
    v_lshlrev_b32 v1, 1, v3
    v_lshl_add_u32 v1, v2, 3, v1
    s_lshr_b32 s35, s30, 1
    s_mul_i32 s35, s35, 288
    s_and_b32 s42, s30, 1
    s_lshl_b32 s42, s42, 7
    s_add_u32 s35, s35, s42
    s_add_u32 s35, s35, 155648
    v_add_u32 v13, s35, v1
    s_mul_i32 s35, s30, 160
    s_add_u32 s35, s35, 158976
    v_add_u32 v16, s35, v1
    v_xor_b32 v1, v3, v2
    v_lshlrev_b32 v1, 4, v1
    v_lshl_add_u32 v1, v2, 8, v1
    s_lshl_b32 s35, s30, 13
    v_add_u32 v20, s35, v1
    v_xor_b32 v21, 64, v20
    v_xor_b32 v22, 128, v20
    v_xor_b32 v23, 192, v20
    v_and_b32 v1, 3, v0
    v_mul_u32_u24 v17, 288, v1
    v_lshl_add_u32 v17, v3, 4, v17
    v_add_u32 v17, 155648, v17
    v_lshlrev_b32 v18, 5, v1
    v_add_u32 v18, 160256, v18
    s_lshl_b32 s35, s30, 2
    v_add_u32 v19, s35, v18
    v_mul_u32_u24 v2, 544, v1
    v_lshl_add_u32 v118, v3, 4, v2
    v_add_u32 v118, 156800, v118
    v_lshrrev_b32 v1, 2, v0
    v_lshl_add_u32 v2, v1, 1, v2
    s_lshl_b32 s35, s30, 6
    s_add_u32 s35, s35, 156800
    v_add_u32 v119, s35, v2
    s_mov_b32 s37, 0
    v_and_b32 v1, 3, v0
    v_bfe_u32 v2, v0, 2, 2
    v_lshl_add_u32 v2, v3, 3, v2
    v_bfe_u32 v144, v0, 2, 3
    v_xor_b32 v144, s30, v144
    v_lshlrev_b32 v144, 5, v144
    v_lshl_add_u32 v144, v2, 8, v144
    v_lshl_add_u32 v144, v1, 3, v144
    v_add_u32 v144, 65536, v144
    s_lshl_b32 s35, s2, 7
    s_add_u32 s35, s35, 0
    v_lshl_add_u32 v148, v1, 4, s35
    v_and_b32 v1, 3, v0
    s_lshl_b32 s35, s26, 16
    s_lshl_b32 s42, s27, 9
    s_add_u32 s35, s35, s42
    s_lshl_b32 s42, s30, 6
    s_add_u32 s35, s35, s42
    s_add_u32 s35, s35, 1015808
    v_lshlrev_b32 v2, 14, v1
    v_lshl_add_u32 v2, v3, 4, v2
    v_add_u32 v145, s35, v2
    s_lshl_b32 s35, s33, 14
    s_lshl_b32 s43, s30, 11
    s_add_u32 s35, s35, s43
    s_add_u32 s35, s35, 1015808
    v_lshl_add_u32 v146, v0, 4, s35
    v_and_b32 v2, 31, v0
    v_lshrrev_b32 v149, 5, v0
    v_lshlrev_b32 v149, 2, v149
    v_lshl_add_u32 v149, v2, 3, v149
    s_mul_i32 s35, s30, 288
    v_add_u32 v149, s35, v149
    v_and_b32 v1, 7, v0
    v_mul_u32_u24 v150, 160, v1
    v_lshl_add_u32 v150, v3, 4, v150
    v_add_u32 v150, 158976, v150
    v_mul_u32_u24 v151, 288, v1
    v_lshl_add_u32 v151, v3, 4, v151
    s_lshl_b32 s35, s64, 2
    s_add_u32 s35, s35, s47
    s_lshl_b32 s35, s35, 14
    s_lshl_b32 s42, s33, 7
    s_add_u32 s35, s35, s42
    s_add_u32 s35, s35, 1540096
    v_lshrrev_b32 v152, 1, v1
    v_lshlrev_b32 v152, 12, v152
    v_and_b32 v2, 1, v1
    v_lshl_add_u32 v152, v2, 6, v152
    v_lshl_add_u32 v152, v3, 4, v152
    v_add_u32 v152, s35, v152
    s_lshl_b32 s35, s33, 14
    s_lshr_b32 s42, s28, 1
    s_lshl_b32 s42, s42, 12
    s_add_u32 s35, s35, s42
    s_and_b32 s42, s28, 1
    s_lshl_b32 s42, s42, 6
    s_add_u32 s35, s35, s42
    s_add_u32 s35, s35, 1540096
    v_lshrrev_b32 v153, 2, v0
    v_lshlrev_b32 v153, 7, v153
    v_and_b32 v2, 3, v0
    v_lshl_add_u32 v153, v2, 4, v153
    v_add_u32 v153, s35, v153
    s_lshl_b32 s46, s30, 12
    s_lshl_b32 s42, s26, 7
    s_add_u32 s46, s46, s42
    s_lshl_b32 s42, s29, 4
    s_add_u32 s46, s46, s42
    s_add_u32 s46, s46, 0
    v_and_b32 v1, 3, v0
    v_lshl_add_u32 v147, v1, 10, s46
    s_branch L_gp
L_gp_z:
    s_sleep 2
L_gp:
    ds_read_b32 v1, v8 offset:0
    s_waitcnt lgkmcnt(0)
    v_readfirstlane_b32 s35, v1
    s_cmp_lt_u32 s35, 1
    s_cbranch_scc1 L_gp_z
    global_load_dwordx4 v[128:131], v10, s[24:25] sc1 nt
    s_sleep 16
L_q_loop:
    global_load_dwordx4 v[132:135], v10, s[24:25] sc1 nt
    s_waitcnt vmcnt(1)
    v_xor_b32 v24, s60, v128
    v_xor_b32 v25, s61, v129
    v_xor_b32 v26, s62, v130
    v_xor_b32 v27, s63, v131
    v_or3_b32 v36, v24, v25, v26
    v_or_b32 v36, v36, v27
    v_and_b32 v36, 0xff, v36
    v_cmp_ne_u32 vcc, 0, v36
    s_add_u32 s37, s37, 1
    s_cbranch_vccz L_q_got
    s_sleep 2
    global_load_dwordx4 v[128:131], v10, s[24:25] sc1 nt
    s_waitcnt vmcnt(1)
    v_xor_b32 v24, s60, v132
    v_xor_b32 v25, s61, v133
    v_xor_b32 v26, s62, v134
    v_xor_b32 v27, s63, v135
    v_or3_b32 v36, v24, v25, v26
    v_or_b32 v36, v36, v27
    v_and_b32 v36, 0xff, v36
    v_cmp_ne_u32 vcc, 0, v36
    s_add_u32 s37, s37, 1
    s_cbranch_vccz L_q_got
    s_sleep 2
    s_cmp_lt_u32 s37, 8
    s_cbranch_scc1 L_qf1
    v_mov_b32 v36, 0x10000
    ds_or_b32 v8, v36 offset:12
L_qf1:
    ds_read_b32 v1, v8 offset:12
    s_waitcnt lgkmcnt(0)
    v_readfirstlane_b32 s35, v1
    s_cmp_lt_u32 s35, 0x10000
    s_cbranch_scc1 L_qf2
    s_cmp_lg_u32 s55, 0
    s_cbranch_scc1 L_qf2
    s_mov_b32 s55, 1
    s_mov_b64 s[58:59], exec
    s_mov_b32 exec_lo, 0x00ff00ff
    s_mov_b32 exec_hi, 0x00ff00ff
    global_store_dwordx4 v116, v[112:115], s[24:25] sc1
    s_mov_b64 exec, s[58:59]
L_qf2:
    s_cmp_le_u32 s37, 4194304
    s_cbranch_scc1 L_q_loop
L_q_got:
    s_cmp_eq_u32 s26, 0
    s_cbranch_scc1 L_nohl
    global_load_dwordx4 v[28:31], v11, s[24:25] sc1 nt
    global_load_dwordx4 v[32:35], v12, s[24:25] sc1 nt
L_nohl:
    v_or3_b32 v36, v24, v25, v26
    v_or_b32 v36, v36, v27
    v_and_b32 v36, 0x100, v36
    v_cmp_ne_u32 vcc, 0, v36
    v_and_b32 v24, v60, v24
    v_and_b32 v25, v60, v25
    v_and_b32 v26, v60, v26
    v_and_b32 v27, v60, v27
    s_cmp_lg_u64 vcc, 0
    s_cselect_b32 s42, 0x10001, 1
    v_mov_b32 v36, s42
    s_nop 1
    v_permlane32_swap_b32 v24, v26
    v_permlane32_swap_b32 v25, v27
    v_add_f32 v24, v24, v26
    v_add_f32 v25, v25, v27
    s_nop 1
    v_permlane16_swap_b32 v24, v25
    v_add_f32 v24, v24, v25
    v_cvt_pk_bf16_f32 v24, v24, v24
    ds_write_b16 v13, v24
    s_mov_b64 exec, 1
    ds_add_u32 v8, v36 offset:12
    s_mov_b64 exec, -1
    s_branch L_kl
L_kl_z:
    s_sleep 2
L_kl:
    ds_read_b32 v1, v8 offset:24
    s_waitcnt lgkmcnt(0)
    v_readfirstlane_b32 s35, v1
    s_cmp_lt_u32 s35, 1
    s_cbranch_scc1 L_kl_z
    ds_read_b128 v[40:43], v20 offset:0
    ds_read_b128 v[44:47], v21 offset:0
    ds_read_b128 v[48:51], v22 offset:0
    ds_read_b128 v[52:55], v23 offset:0
    ds_read_b128 v[56:59], v20 offset:4096
    ds_read_b128 v[60:63], v21 offset:4096
    ds_read_b128 v[64:67], v22 offset:4096
    ds_read_b128 v[68:71], v23 offset:4096
L_s1:
    ds_read_b32 v1, v8 offset:12
    s_waitcnt lgkmcnt(0)
    v_readfirstlane_b32 s42, v1
    s_lshr_b32 s54, s42, 16
    s_cbranch_scc0 L_s1b
    s_cmp_lg_u32 s55, 0
    s_cbranch_scc1 L_s1b
    s_mov_b32 s55, 1
    s_mov_b64 s[58:59], exec
    s_mov_b32 exec_lo, 0x00ff00ff
    s_mov_b32 exec_hi, 0x00ff00ff
    global_store_dwordx4 v116, v[112:115], s[24:25] sc1
    s_mov_b64 exec, s[58:59]
L_s1b:
    s_and_b32 s35, s42, 0xffff
    s_cmp_lt_u32 s35, 8
    s_cbranch_scc1 L_s1
    ds_read_b128 v[72:75], v17 offset:0
    ds_read_b128 v[76:79], v17 offset:64
    ds_read_b128 v[80:83], v17 offset:128
    ds_read_b128 v[84:87], v17 offset:192
    s_waitcnt lgkmcnt(3)
    v_mfma_f32_16x16x32_bf16 v[88:91], v[40:43], v[72:75], 0
    v_mfma_f32_16x16x32_bf16 v[92:95], v[56:59], v[72:75], 0
    s_waitcnt lgkmcnt(2)
    v_mfma_f32_16x16x32_bf16 v[88:91], v[44:47], v[76:79], v[88:91]
    v_mfma_f32_16x16x32_bf16 v[92:95], v[60:63], v[76:79], v[92:95]
    s_waitcnt lgkmcnt(1)
    v_mfma_f32_16x16x32_bf16 v[88:91], v[48:51], v[80:83], v[88:91]
    v_mfma_f32_16x16x32_bf16 v[92:95], v[64:67], v[80:83], v[92:95]
    s_waitcnt lgkmcnt(0)
    v_mfma_f32_16x16x32_bf16 v[88:91], v[52:55], v[84:87], v[88:91]
    v_mfma_f32_16x16x32_bf16 v[92:95], v[68:71], v[84:87], v[92:95]
    s_nop 7
    v_mov_b32_dpp v88, v89 quad_perm:[0,1,2,3] row_mask:0xf bank_mask:0x2
    v_mov_b32_dpp v92, v93 quad_perm:[0,1,2,3] row_mask:0xf bank_mask:0x2
    s_nop 0
    v_mov_b32_dpp v88, v90 quad_perm:[0,1,2,3] row_mask:0xf bank_mask:0x4
    v_mov_b32_dpp v92, v94 quad_perm:[0,1,2,3] row_mask:0xf bank_mask:0x4
    s_nop 0
    v_mov_b32_dpp v88, v91 quad_perm:[0,1,2,3] row_mask:0xf bank_mask:0x8
    v_mov_b32_dpp v92, v95 quad_perm:[0,1,2,3] row_mask:0xf bank_mask:0x8
    v_cvt_pk_bf16_f32 v89, v88, v92
    v_lshlrev_b32 v88, 16, v89
    v_and_b32 v92, 0xffff0000, v89
    v_mul_f32 v88, 0x3db504f3, v88
    v_mul_f32 v92, 0x3db504f3, v92
    v_cvt_pk_bf16_f32 v89, v88, v92
    v_lshlrev_b32 v88, 16, v89
    v_and_b32 v92, 0xffff0000, v89
    v_max_f32 v90, v88, v92
    s_nop 1
    v_max_f32_dpp v90, v90, v90 row_ror:4 row_mask:0xf bank_mask:0xf
    s_nop 1
    v_max_f32_dpp v90, v90, v90 row_ror:8 row_mask:0xf bank_mask:0xf
    v_mov_b32 v91, v90
    s_nop 1
    v_permlane16_swap_b32 v90, v91
    v_max_f32 v90, v90, v91
    v_mov_b32 v91, v90
    s_nop 1
    v_permlane32_swap_b32 v90, v91
    v_max_f32 v90, v90, v91
    s_mov_b64 exec, 15
    ds_write_b32 v19, v90
    s_mov_b64 exec, 1
    ds_add_u32 v8, v9 offset:16
    s_mov_b64 exec, -1
L_s2:
    ds_read_b32 v1, v8 offset:16
    s_waitcnt lgkmcnt(0)
    v_readfirstlane_b32 s35, v1
    s_cmp_lt_u32 s35, 8
    s_cbranch_scc1 L_s2
    ds_read_b128 v[96:99], v18
    ds_read_b128 v[100:103], v18 offset:16
    s_waitcnt lgkmcnt(0)
    v_max3_f32 v96, v96, v97, v98
    v_max3_f32 v100, v100, v101, v102
    v_max3_f32 v96, v96, v99, v103
    v_max_f32 v96, v96, v100
    v_sub_f32 v88, v88, v96
    v_sub_f32 v92, v92, v96
    v_mul_f32 v88, 0x3fb8aa3b, v88
    v_mul_f32 v92, 0x3fb8aa3b, v92
    v_exp_f32 v88, v88
    v_exp_f32 v92, v92
    s_nop 0
    v_cvt_pk_bf16_f32 v88, v88, v92
    ds_write_b16 v119, v88
    ds_write_b16_d16_hi v119, v88 offset:32
    s_mov_b64 exec, 1
    ds_add_u32 v8, v9 offset:20
    s_mov_b64 exec, -1
L_s3:
    ds_read_b32 v1, v8 offset:20
    s_waitcnt lgkmcnt(0)
    v_readfirstlane_b32 s35, v1
    s_cmp_lt_u32 s35, 8
    s_cbranch_scc1 L_s3
    ds_read_b128 v[40:43], v118 offset:0
    ds_read_b128 v[44:47], v118 offset:64
    ds_read_b128 v[48:51], v118 offset:128
    ds_read_b128 v[52:55], v118 offset:192
    ds_read_b128 v[56:59], v118 offset:256
    ds_read_b128 v[60:63], v118 offset:320
    ds_read_b128 v[64:67], v118 offset:384
    ds_read_b128 v[68:71], v118 offset:448
    s_cmp_lg_u32 s30, 7
    s_cbranch_scc1 L_nostats
    v_mov_b32 v20, 0x3f803f80
    v_mov_b32 v21, 0x3f803f80
    v_mov_b32 v22, 0x3f803f80
    v_mov_b32 v23, 0x3f803f80
    s_nop 0
    s_waitcnt lgkmcnt(0)
    v_mfma_f32_16x16x32_bf16 v[108:111], v[20:23], v[40:43], 0
    v_mfma_f32_16x16x32_bf16 v[108:111], v[20:23], v[44:47], v[108:111]
    v_mfma_f32_16x16x32_bf16 v[108:111], v[20:23], v[48:51], v[108:111]
    v_mfma_f32_16x16x32_bf16 v[108:111], v[20:23], v[52:55], v[108:111]
    v_mfma_f32_16x16x32_bf16 v[108:111], v[20:23], v[56:59], v[108:111]
    v_mfma_f32_16x16x32_bf16 v[108:111], v[20:23], v[60:63], v[108:111]
    v_mfma_f32_16x16x32_bf16 v[108:111], v[20:23], v[64:67], v[108:111]
    v_mfma_f32_16x16x32_bf16 v[108:111], v[20:23], v[68:71], v[108:111]
    v_mov_b32 v24, v96
    v_mov_b32 v26, v96
    s_mov_b64 exec, 15
    s_nop 4
    v_mov_b32 v25, v108
    v_mov_b32 v27, v108
    v_and_or_b32 v24, v24, v6, s68
    v_and_or_b32 v25, v25, v6, s69
    v_and_or_b32 v26, v26, v6, s70
    v_and_or_b32 v27, v27, v6, s71
    s_cmp_lg_u32 s54, 0
    s_cbranch_scc1 L_ps_wt
    global_store_dwordx4 v148, v[24:27], s[24:25]
    s_branch L_ps_ok
L_ps_wt:
    global_store_dwordx4 v148, v[24:27], s[24:25] sc1
L_ps_ok:
    s_mov_b64 exec, -1
L_nostats:
    s_branch L_v5
L_v5_z:
    s_sleep 2
L_v5:
    ds_read_b32 v1, v8 offset:28
    s_waitcnt lgkmcnt(0)
    v_readfirstlane_b32 s35, v1
    s_cmp_lt_u32 s35, 1
    s_cbranch_scc1 L_v5_z
    global_load_dwordx4 v[20:23], v147, s[24:25] sc1 nt
    ds_read_b64_tr_b16 v[72:73], v144 offset:0
    ds_read_b64_tr_b16 v[74:75], v144 offset:1024
    ds_read_b64_tr_b16 v[76:77], v144 offset:8192
    ds_read_b64_tr_b16 v[78:79], v144 offset:9216
    ds_read_b64_tr_b16 v[80:81], v144 offset:16384
    ds_read_b64_tr_b16 v[82:83], v144 offset:17408
    ds_read_b64_tr_b16 v[84:85], v144 offset:24576
    ds_read_b64_tr_b16 v[86:87], v144 offset:25600
    ds_read_b64_tr_b16 v[88:89], v144 offset:32768
    ds_read_b64_tr_b16 v[90:91], v144 offset:33792
    ds_read_b64_tr_b16 v[92:93], v144 offset:40960
    ds_read_b64_tr_b16 v[94:95], v144 offset:41984
    s_waitcnt lgkmcnt(10)
    v_mfma_f32_16x16x32_bf16 v[104:107], v[72:75], v[40:43], 0
    s_waitcnt lgkmcnt(8)
    v_mfma_f32_16x16x32_bf16 v[104:107], v[76:79], v[44:47], v[104:107]
    s_waitcnt lgkmcnt(6)
    v_mfma_f32_16x16x32_bf16 v[104:107], v[80:83], v[48:51], v[104:107]
    s_waitcnt lgkmcnt(4)
    v_mfma_f32_16x16x32_bf16 v[104:107], v[84:87], v[52:55], v[104:107]
    s_waitcnt lgkmcnt(2)
    v_mfma_f32_16x16x32_bf16 v[104:107], v[88:91], v[56:59], v[104:107]
    s_waitcnt lgkmcnt(0)
    v_mfma_f32_16x16x32_bf16 v[104:107], v[92:95], v[60:63], v[104:107]
    s_branch L_v6
L_v6_z:
    s_sleep 1
L_v6:
    ds_read_b32 v1, v8 offset:32
    s_waitcnt lgkmcnt(0)
    v_readfirstlane_b32 s35, v1
    s_cmp_lt_u32 s35, 1
    s_cbranch_scc1 L_v6_z
    ds_read_b64_tr_b16 v[72:73], v144 offset:49152
    ds_read_b64_tr_b16 v[74:75], v144 offset:50176
    s_waitcnt lgkmcnt(0)
    v_mfma_f32_16x16x32_bf16 v[104:107], v[72:75], v[64:67], v[104:107]
    s_barrier
    ds_read_b64_tr_b16 v[72:73], v144 offset:57344
    ds_read_b64_tr_b16 v[74:75], v144 offset:58368
    s_waitcnt lgkmcnt(0)
    v_mfma_f32_16x16x32_bf16 v[104:107], v[72:75], v[68:71], v[104:107]
    s_mov_b32 exec_lo, 0x000f000f
    s_mov_b32 exec_hi, 0x000f000f
    s_nop 5
    v_and_or_b32 v104, v104, v6, s68
    v_and_or_b32 v105, v105, v6, s69
    v_and_or_b32 v106, v106, v6, s70
    v_and_or_b32 v107, v107, v6, s71
    s_cmp_lg_u32 s54, 0
    s_cbranch_scc1 L_po_wt
    global_store_dwordx4 v145, v[104:107], s[24:25]
    s_branch L_po_ok
L_po_wt:
    global_store_dwordx4 v145, v[104:107], s[24:25] sc1
L_po_ok:
    s_mov_b64 exec, -1
    s_cmp_eq_u32 s26, 0
    s_cbranch_scc1 L_hdone
    s_waitcnt vmcnt(2)
    s_branch L_h_chk
L_h_poll:
    global_load_dwordx4 v[28:31], v11, s[24:25] sc1 nt
    global_load_dwordx4 v[32:35], v12, s[24:25] sc1 nt
    s_waitcnt vmcnt(0)
L_h_chk:
    v_xor_b32 v28, s68, v28
    v_xor_b32 v29, s69, v29
    v_xor_b32 v30, s70, v30
    v_xor_b32 v31, s71, v31
    v_xor_b32 v32, s68, v32
    v_xor_b32 v33, s69, v33
    v_xor_b32 v34, s70, v34
    v_xor_b32 v35, s71, v35
    v_or3_b32 v36, v28, v29, v30
    v_or3_b32 v36, v36, v31, v32
    v_or3_b32 v36, v36, v33, v34
    v_bitop3_b32 v36, v36, v35, s36 bitop3:0x54
    v_cmp_ne_u32 vcc, 0, v36
    s_cbranch_vccz L_h_done
    v_or_b32_dpp v36, v36, v36 quad_perm:[1,0,3,2] row_mask:0xf bank_mask:0xf
    s_add_u32 s37, s37, 1
    s_cmp_gt_u32 s37, 4194304
    v_or_b32_dpp v36, v36, v36 quad_perm:[2,3,0,1] row_mask:0xf bank_mask:0xf
    s_cbranch_scc1 L_h_done
    v_cmp_ne_u32 vcc, 0, v36
    s_mov_b64 exec, vcc
    s_branch L_h_poll
L_h_done:
    s_mov_b64 exec, -1
    v_add_f32 v28, v28, v32
    v_add_f32 v29, v29, v33
    v_add_f32 v30, v30, v34
    v_add_f32 v31, v31, v35
    s_nop 1
    v_permlane32_swap_b32 v28, v30
    v_permlane32_swap_b32 v29, v31
    v_add_f32 v28, v28, v30
    v_add_f32 v29, v29, v31
    s_nop 1
    v_permlane16_swap_b32 v28, v29
    v_add_f32 v28, v28, v29
    v_cvt_pk_bf16_f32 v28, v28, v28
    v_lshlrev_b32 v28, 16, v28
    v_mul_f32 v29, 0xbfb8aa3b, v28
    v_exp_f32 v29, v29
    s_nop 0
    v_add_f32 v29, 1.0, v29
    v_rcp_f32 v29, v29
    s_nop 0
    v_mul_f32 v28, v28, v29
    v_cvt_pk_bf16_f32 v28, v28, v28
    ds_write_b16 v16, v28
L_hdone:
    s_waitcnt vmcnt(2) lgkmcnt(0)
    s_barrier
    global_load_dwordx4 v[24:27], v146, s[24:25] sc1 nt
    global_load_dwordx4 v[28:31], v146, s[24:25] offset:1024 sc1 nt
    s_cmp_ge_u32 s30, 4
    s_cbranch_scc1 L_nowe
    ds_read_b64_tr_b16 v[128:129], v7 offset:0
    ds_read_b64_tr_b16 v[130:131], v7 offset:512
    ds_read_b64_tr_b16 v[132:133], v7 offset:4096
    ds_read_b64_tr_b16 v[134:135], v7 offset:4608
    v_mov_b32 v108, 0
    v_mov_b32 v109, 0
    v_mov_b32 v110, 0
    v_mov_b32 v111, 0
    s_cmp_eq_u32 s26, 0
    s_cbranch_scc1 L_nowe
    ds_read_b64_tr_b16 v[72:73], v7 offset:16384
    ds_read_b64_tr_b16 v[74:75], v7 offset:16896
    ds_read_b64_tr_b16 v[76:77], v7 offset:20480
    ds_read_b64_tr_b16 v[78:79], v7 offset:20992
    ds_read_b128 v[80:83], v150
    ds_read_b128 v[84:87], v150 offset:64
    s_waitcnt lgkmcnt(0)
    v_mfma_f32_16x16x32_bf16 v[108:111], v[72:75], v[80:83], 0
    v_mfma_f32_16x16x32_bf16 v[108:111], v[76:79], v[84:87], v[108:111]
L_nowe:
    s_waitcnt vmcnt(3)
    s_branch L_st_chk
L_st_poll:
    global_load_dwordx4 v[20:23], v147, s[24:25] sc1 nt
    s_waitcnt vmcnt(0)
L_st_chk:
    v_xor_b32 v20, s68, v20
    v_xor_b32 v21, s69, v21
    v_xor_b32 v22, s70, v22
    v_xor_b32 v23, s71, v23
    v_or3_b32 v36, v20, v21, v22
    v_bitop3_b32 v36, v36, v23, s36 bitop3:0x54
    v_xor_b32 v22, v20, v22
    v_xor_b32 v23, v21, v23
    v_or3_b32 v36, v36, v22, v23
    v_cmp_ne_u32 vcc, 0, v36
    s_cbranch_vccz L_st_done
    v_or_b32_dpp v36, v36, v36 quad_perm:[1,0,3,2] row_mask:0xf bank_mask:0xf
    s_add_u32 s37, s37, 1
    s_cmp_gt_u32 s37, 4194304
    v_or_b32_dpp v36, v36, v36 quad_perm:[2,3,0,1] row_mask:0xf bank_mask:0xf
    s_cbranch_scc1 L_st_done
    v_cmp_ne_u32 vcc, 0, v36
    s_mov_b64 exec, vcc
    s_branch L_st_poll
L_st_done:
    s_mov_b64 exec, -1
    v_max_f32_dpp v22, v20, v20 quad_perm:[1,0,3,2] row_mask:0xf bank_mask:0xf
    s_nop 1
    v_max_f32_dpp v22, v22, v22 quad_perm:[2,3,0,1] row_mask:0xf bank_mask:0xf
    v_sub_f32 v20, v20, v22
    v_mul_f32 v20, 0x3fb8aa3b, v20
    v_exp_f32 v20, v20
    s_nop 0
    v_mul_f32 v21, v20, v21
    s_nop 1
    v_add_f32_dpp v21, v21, v21 quad_perm:[1,0,3,2] row_mask:0xf bank_mask:0xf
    s_nop 1
    v_add_f32_dpp v21, v21, v21 quad_perm:[2,3,0,1] row_mask:0xf bank_mask:0xf
    v_rcp_f32 v21, v21
    s_nop 0
    v_mul_f32 v20, v20, v21
    s_nop 1
    v_mov_b32_dpp v22, v20 quad_perm:[0,0,0,0] row_mask:0x3 bank_mask:0xf
    v_mov_b32_dpp v23, v20 quad_perm:[2,2,2,2] row_mask:0x3 bank_mask:0xf
    s_nop 0
    v_mov_b32_dpp v22, v20 quad_perm:[1,1,1,1] row_mask:0xc bank_mask:0xf
    v_mov_b32_dpp v23, v20 quad_perm:[3,3,3,3] row_mask:0xc bank_mask:0xf
    s_barrier
    ds_read_b64_tr_b16 v[136:137], v7 offset:8192
    ds_read_b64_tr_b16 v[138:139], v7 offset:8704
    ds_read_b64_tr_b16 v[140:141], v7 offset:12288
    ds_read_b64_tr_b16 v[142:143], v7 offset:12800
    s_waitcnt vmcnt(0)
    s_branch L_o_chk
L_o_poll:
    global_load_dwordx4 v[24:27], v146, s[24:25] sc1 nt
    global_load_dwordx4 v[28:31], v146, s[24:25] offset:1024 sc1 nt
    s_waitcnt vmcnt(0)
L_o_chk:
    v_xor_b32 v24, s68, v24
    v_xor_b32 v25, s69, v25
    v_xor_b32 v26, s70, v26
    v_xor_b32 v27, s71, v27
    v_xor_b32 v28, s68, v28
    v_xor_b32 v29, s69, v29
    v_xor_b32 v30, s70, v30
    v_xor_b32 v31, s71, v31
    v_or3_b32 v36, v24, v25, v26
    v_or3_b32 v36, v36, v27, v28
    v_or3_b32 v36, v36, v29, v30
    v_bitop3_b32 v36, v36, v31, s36 bitop3:0x54
    v_cmp_ne_u32 vcc, 0, v36
    s_cbranch_vccz L_o_done
    v_or_b32_dpp v36, v36, v36 quad_perm:[1,0,3,2] row_mask:0xf bank_mask:0xf
    s_add_u32 s37, s37, 1
    s_cmp_gt_u32 s37, 4194304
    v_or_b32_dpp v36, v36, v36 quad_perm:[2,3,0,1] row_mask:0xf bank_mask:0xf
    s_cbranch_scc1 L_o_done
    v_cmp_ne_u32 vcc, 0, v36
    s_mov_b64 exec, vcc
    s_branch L_o_poll
L_o_done:
    s_mov_b64 exec, -1
    v_pk_mul_f32 v[24:25], v[24:25], v[22:23] op_sel_hi:[1,0]
    v_pk_mul_f32 v[26:27], v[26:27], v[22:23] op_sel_hi:[1,0]
    v_pk_fma_f32 v[24:25], v[28:29], v[22:23], v[24:25] op_sel:[0,1,0] op_sel_hi:[1,1,1]
    v_pk_fma_f32 v[26:27], v[30:31], v[22:23], v[26:27] op_sel:[0,1,0] op_sel_hi:[1,1,1]
    s_nop 1
    v_permlane32_swap_b32 v24, v26
    v_permlane32_swap_b32 v25, v27
    v_pk_add_f32 v[24:25], v[24:25], v[26:27]
    v_cvt_pk_bf16_f32 v24, v24, v25
    ds_write_b32 v149, v24
    s_waitcnt lgkmcnt(0)
    s_barrier
    s_cmp_ge_u32 s30, 4
    s_cbranch_scc1 L_clean
    ds_read_b128 v[40:43], v151 offset:0
    ds_read_b128 v[44:47], v151 offset:64
    ds_read_b128 v[48:51], v151 offset:128
    ds_read_b128 v[52:55], v151 offset:192
    s_waitcnt lgkmcnt(3)
    v_mfma_f32_16x16x32_bf16 v[108:111], v[128:131], v[40:43], v[108:111]
    s_waitcnt lgkmcnt(2)
    v_mfma_f32_16x16x32_bf16 v[108:111], v[132:135], v[44:47], v[108:111]
    s_waitcnt lgkmcnt(1)
    v_mfma_f32_16x16x32_bf16 v[108:111], v[136:139], v[48:51], v[108:111]
    s_waitcnt lgkmcnt(0)
    v_mfma_f32_16x16x32_bf16 v[108:111], v[140:143], v[52:55], v[108:111]
    s_mov_b32 exec_lo, 0x00ff00ff
    s_mov_b32 exec_hi, 0x00ff00ff
    s_nop 5
    v_and_or_b32 v108, v108, v6, s68
    v_and_or_b32 v109, v109, v6, s69
    v_and_or_b32 v110, v110, v6, s70
    v_and_or_b32 v111, v111, v6, s71
    global_store_dwordx4 v152, v[108:111], s[24:25] sc1
    s_mov_b64 exec, -1
L_clean:
    s_cmp_gt_u32 s30, 0
    s_cbranch_scc1 L_fin
    v_and_b32 v1, 31, v117
    v_add_u32 v1, 163776, v1
    ds_read_u16 v2, v1
    s_waitcnt lgkmcnt(0)
    v_lshlrev_b32 v2, 16, v2
    s_mov_b32 s56, 0x000f000f
    s_mov_b32 s57, 0x000f000f
    s_sleep 14
L_f_poll:
    global_load_dwordx4 v[24:27], v153, s[24:25] sc1
    global_load_dwordx4 v[28:31], v153, s[24:25] offset:2048 sc1
    s_waitcnt vmcnt(0)
L_f_chk:
    v_xor_b32 v24, s68, v24
    v_xor_b32 v25, s69, v25
    v_xor_b32 v26, s70, v26
    v_xor_b32 v27, s71, v27
    v_xor_b32 v28, s68, v28
    v_xor_b32 v29, s69, v29
    v_xor_b32 v30, s70, v30
    v_xor_b32 v31, s71, v31
    v_or3_b32 v36, v24, v25, v26
    v_or3_b32 v36, v36, v27, v28
    v_or3_b32 v36, v36, v29, v30
    v_bitop3_b32 v36, v36, v31, s36 bitop3:0x54
    v_cmp_ne_u32 vcc, 0, v36
    s_cbranch_vccz L_f_done
    v_or_b32_dpp v36, v36, v36 quad_perm:[1,0,3,2] row_mask:0xf bank_mask:0xf
    s_add_u32 s37, s37, 1
    s_cmp_gt_u32 s37, 4194304
    v_or_b32_dpp v36, v36, v36 quad_perm:[2,3,0,1] row_mask:0xf bank_mask:0xf
    s_cbranch_scc1 L_f_done
    v_cmp_ne_u32 vcc, 0, v36
    s_mov_b64 exec, vcc
    s_branch L_f_poll
L_f_done:
    s_mov_b64 exec, -1
    v_pk_add_f32 v[24:25], v[24:25], v[28:29]
    v_pk_add_f32 v[26:27], v[26:27], v[30:31]
    s_nop 1
    v_permlane32_swap_b32 v24, v26
    v_permlane32_swap_b32 v25, v27
    v_pk_add_f32 v[24:25], v[24:25], v[26:27]
    s_nop 1
    v_permlane16_swap_b32 v24, v25
    v_add_f32 v24, v24, v25
    s_nop 1
    v_add_f32_dpp v24, v24, v24 row_ror:4 row_mask:0xf bank_mask:0xf
    s_nop 1
    v_add_f32_dpp v24, v24, v24 row_ror:8 row_mask:0xf bank_mask:0xf
    v_add_f32 v24, v24, v2
    s_mov_b64 exec, s[56:57]
    v_cvt_pk_bf16_f32 v24, v24, v24
    global_store_short v117, v24, s[20:21]
    s_cmp_lg_u32 s2, 0
    s_cbranch_scc1 L_fin0
    s_mov_b64 exec, 1
    v_mov_b32 v1, 2064384
    v_mov_b32 v2, s31
    global_store_dword v1, v2, s[24:25]
L_fin0:
    s_mov_b64 exec, -1
L_fin:
L_end:
    s_endpgm
.section .rodata,"a"
.p2align 6
.amdhsa_kernel parallel_sum__sliding_block_cached__dense_activation_silu__decode_kernel
  .amdhsa_next_free_vgpr 160
  .amdhsa_next_free_sgpr 96
  .amdhsa_accum_offset 160
  .amdhsa_group_segment_fixed_size 0
  .amdhsa_kernarg_size 88
  .amdhsa_user_sgpr_count 2
  .amdhsa_user_sgpr_kernarg_segment_ptr 1
  .amdhsa_system_sgpr_workgroup_id_x 1
  .amdhsa_float_denorm_mode_32 3
.end_amdhsa_kernel
```
